```python
import torch

def _softmax(x, axis=-1):
    return torch.softmax(x, dim=axis)

def _gelu(x):
    return torch.nn.functional.gelu(x, approximate='tanh')

def _silu(x):
    return torch.nn.functional.silu(x)

def _sigmoid(x):
    return torch.sigmoid(x)

def _layernorm(x, axis=-1, eps=1e-05):
    m = x.mean(dim=axis, keepdim=True)
    v = x.var(dim=axis, keepdim=True, unbiased=False)
    return (x - m) / torch.sqrt(v + eps)

def _scatter_add(tgt, idx, src, axis=0):
    return tgt.clone().index_add_(axis, idx, src)

def _segment_sum(src, seg, n):
    out = torch.zeros((n,) + src.shape[1:], dtype=src.dtype)
    return out.index_add_(0, seg, src)

def _pad(x, pw):
    flat = tuple((v for pair in reversed(pw) for v in pair))
    return torch.nn.functional.pad(x, flat)
kernel_name = 'standalone__tree_speculative_verify_tree_attention_over_candidate_token_tree__decode'

def setup_inputs():

    _w = lambda a: (lambda t: t.to(torch.bfloat16) if t.is_floating_point() else t)(torch.as_tensor(a))
    B, Hq, Hkv, T, C, D = (1, 32, 8, 1, 32768, 128)
    tree_mask = torch.zeros((B, T, T), dtype=float)
    for b in range(B):
        parent = torch.zeros(T, dtype=torch.int64)
        for i in range(1, T):
            parent[i] = int(torch.randint(0, i, (1,)).item())
        for i in range(T):
            j = i
            tree_mask[b, i, j] = 1.0
            while j > 0:
                j = parent[j]
                tree_mask[b, i, j] = 1.0
    return {'q': _w((lambda *s: torch.randn(*s, dtype=torch.bfloat16) * 0.8)(B, Hq, T, D)), 'k_cache': _w((lambda *s: torch.randn(*s, dtype=torch.bfloat16) * 0.8)(B, Hkv, C, D)), 'v_cache': _w((lambda *s: torch.randn(*s, dtype=torch.bfloat16) * 0.05)(B, Hkv, C, D)), 'k_tree': _w((lambda *s: torch.randn(*s, dtype=torch.bfloat16) * 0.8)(B, Hkv, T, D)), 'v_tree': _w((lambda *s: torch.randn(*s, dtype=torch.bfloat16) * 0.05)(B, Hkv, T, D)), 'tree_mask': _w(tree_mask)}

def reference(q, k_cache, v_cache, k_tree, v_tree, tree_mask):
    B, Hq, T, D = q.shape
    Hkv, C = (k_cache.shape[1], k_cache.shape[2])
    rep = Hq // Hkv
    kc = (lambda x, n, axis: torch.repeat_interleave(x, n, dim=axis))(k_cache, rep, axis=1)
    vc = (lambda x, n, axis: torch.repeat_interleave(x, n, dim=axis))(v_cache, rep, axis=1)
    kt = (lambda x, n, axis: torch.repeat_interleave(x, n, dim=axis))(k_tree, rep, axis=1)
    vt = (lambda x, n, axis: torch.repeat_interleave(x, n, dim=axis))(v_tree, rep, axis=1)
    k = torch.concatenate([kc, kt], axis=2)
    v = torch.concatenate([vc, vt], axis=2)
    scale = D ** (-0.5)
    scores = torch.einsum('bhqd,bhkd->bhqk', q, k) * scale
    ctx_mask = torch.ones((B, 1, T, C), dtype=scores.dtype)
    tm = tree_mask[:, None, :, :].clone()
    full_mask = torch.concatenate([ctx_mask, tm], axis=-1)
    scores = scores + (1.0 - full_mask) * -1000000000.0
    p = _softmax(scores, axis=-1)
    return torch.einsum('bhqk,bhkd->bhqd', p, v)
```

```asm
; @launch grid=(256,1,1) block=(192,1,1) lds=4112
.amdgcn_target "amdgcn-amd-amdhsa--gfx950"
.text
.globl standalone__tree_speculative_verify_tree_attention_over_candidate_token_tree__decode_kernel
.p2align 8
.type standalone__tree_speculative_verify_tree_attention_over_candidate_token_tree__decode_kernel,@function
standalone__tree_speculative_verify_tree_attention_over_candidate_token_tree__decode_kernel:
    s_load_dwordx16 s[4:19], s[0:1], 0
    s_getpc_b64 s[28:29]
    v_mad_u64_u32 v[2:3], vcc, v0, 36, s[28:29]
    global_load_dword v55, v[2:3], off
    s_lshr_b32 s23, s2, 3
    s_cmp_gt_u32 s23, 31
    s_cbranch_scc1 L_end
    v_lshlrev_b32 v52, 3, v0
    v_mov_b64 v[8:9], -1
    ds_write_b64 v52, v[8:9]
    v_readfirstlane_b32 s3, v0
    s_and_b32 s22, s2, 7
    v_and_b32 v5, 3, v0
    v_and_b32 v57, 48, v0
    v_lshl_or_b32 v57, v5, 2, v57
    v_and_b32 v5, 12, v0
    v_lshl_or_b32 v57, v5, 4, v57
    s_lshl_b32 s30, s22, 5
    s_add_u32 s30, s30, s23
    s_lshl_b32 s28, s30, 18
    s_lshl_b32 s29, s22, 10
    v_lshl_add_u32 v6, v57, 2, s29
    s_add_u32 s29, s3, 32
    s_lshl_b32 s29, s29, 7
    v_lshl_add_u32 v1, v57, 2, s29
    s_waitcnt lgkmcnt(0)
    s_add_u32 s32, s6, s28
    s_addc_u32 s33, s7, 0
    s_bitcmp1_b32 s3, 7
    s_cbranch_scc1 L_bar
    global_load_dwordx4 v[10:13], v6, s[4:5]
    global_load_dwordx4 v[90:93], v1, s[32:33] offset:-4096 nt
    global_load_dwordx4 v[94:97], v1, s[32:33] offset:-3072 nt
    global_load_dwordx4 v[98:101], v1, s[32:33] offset:-2048 nt
    global_load_dwordx4 v[102:105], v1, s[32:33] offset:-1024 nt
    global_load_dwordx4 v[106:109], v1, s[32:33] offset:0 nt
    global_load_dwordx4 v[110:113], v1, s[32:33] offset:1024 nt
    global_load_dwordx4 v[114:117], v1, s[32:33] offset:2048 nt
    global_load_dwordx4 v[118:121], v1, s[32:33] offset:3072 nt
    v_add_u32 v1, 16384, v1
    global_load_dwordx4 v[122:125], v1, s[32:33] offset:-4096 nt
    global_load_dwordx4 v[126:129], v1, s[32:33] offset:-3072 nt
L_bar:
    s_barrier
    s_cbranch_scc1 L_helper
    global_load_dwordx4 v[130:133], v1, s[32:33] offset:-2048 nt
    global_load_dwordx4 v[134:137], v1, s[32:33] offset:-1024 nt
    global_load_dwordx4 v[138:141], v1, s[32:33] offset:0 nt
    s_load_dwordx2 s[20:21], s[0:1], 64
    v_and_b32 v51, 63, v0
    s_add_u32 s34, s8, s28
    s_addc_u32 s35, s9, 0
    v_lshl_add_u32 v2, v51, 4, s29
    s_mov_b32 s25, 0x3e0293ee
    s_mov_b32 s26, 0xbe0293ee
    s_mov_b32 s48, 0xaaaaaaaa
    s_mov_b32 s49, 0xaaaaaaaa
    s_mov_b32 s50, 0xcccccccc
    s_mov_b32 s51, 0xcccccccc
    v_and_b32 v5, 1, v51
    v_lshlrev_b32 v5, 4, v5
    v_mov_b32 v6, 0xffff
    v_lshlrev_b32 v5, v5, v6
    v_bfe_i32 v6, v51, 1, 1
    v_and_b32 v4, v6, v5
    v_xor_b32 v3, v4, v5
    v_lshlrev_b32 v50, 3, v51
    v_lshlrev_b32 v48, 4, v0
    v_xor_b32 v49, 0x400, v48
    s_lshl_b32 s28, s30, 10
    v_add_u32 v53, s28, v52
    v_mov_b64 v[14:15], 0
    v_mov_b64 v[16:17], 0
    v_mov_b64 v[18:19], 0
    v_mov_b64 v[20:21], 0
    v_mov_b32 v6, 0xff800000
    s_mov_b32 s27, 8
L_kloop:
    s_cmp_eq_u32 s27, 1
    s_waitcnt vmcnt(9)
    global_load_dwordx4 v[142:145], v1, s[32:33] offset:1024 nt
    v_mfma_f32_16x16x32_bf16 v[22:25], v[90:93], v[10:13], 0
    v_mfma_f32_16x16x32_bf16 v[26:29], v[94:97], v[10:13], 0
    v_mfma_f32_16x16x32_bf16 v[30:33], v[98:101], v[10:13], 0
    v_mfma_f32_16x16x32_bf16 v[34:37], v[102:105], v[10:13], 0
    s_waitcnt vmcnt(9)
    global_load_dwordx4 v[146:149], v1, s[32:33] offset:2048 nt
    v_mov_b64 v[58:59], v[62:63]
    v_mov_b64 v[60:61], v[64:65]
    v_mov_b64 v[62:63], v[66:67]
    v_mov_b64 v[64:65], v[68:69]
    v_mov_b32_dpp v38, v22 quad_perm:[0,0,0,0] row_mask:0xf bank_mask:0xf
    v_mov_b32_dpp v39, v26 quad_perm:[0,0,0,0] row_mask:0xf bank_mask:0xf
    v_mov_b32_dpp v40, v30 quad_perm:[0,0,0,0] row_mask:0xf bank_mask:0xf
    v_mov_b32_dpp v41, v34 quad_perm:[0,0,0,0] row_mask:0xf bank_mask:0xf
    v_add_f32_dpp v38, v23, v38 quad_perm:[1,1,1,1] row_mask:0xf bank_mask:0xf
    v_add_f32_dpp v39, v27, v39 quad_perm:[1,1,1,1] row_mask:0xf bank_mask:0xf
    v_add_f32_dpp v40, v31, v40 quad_perm:[1,1,1,1] row_mask:0xf bank_mask:0xf
    v_add_f32_dpp v41, v35, v41 quad_perm:[1,1,1,1] row_mask:0xf bank_mask:0xf
    s_waitcnt vmcnt(9)
    global_load_dwordx4 v[150:153], v1, s[32:33] offset:3072 nt
    v_add_u32 v1, 16384, v1
    v_add_f32_dpp v38, v24, v38 quad_perm:[2,2,2,2] row_mask:0xf bank_mask:0xf
    v_add_f32_dpp v39, v28, v39 quad_perm:[2,2,2,2] row_mask:0xf bank_mask:0xf
    v_add_f32_dpp v40, v32, v40 quad_perm:[2,2,2,2] row_mask:0xf bank_mask:0xf
    v_add_f32_dpp v41, v36, v41 quad_perm:[2,2,2,2] row_mask:0xf bank_mask:0xf
    v_add_f32_dpp v38, v25, v38 quad_perm:[3,3,3,3] row_mask:0xf bank_mask:0xf
    v_add_f32_dpp v39, v29, v39 quad_perm:[3,3,3,3] row_mask:0xf bank_mask:0xf
    v_add_f32_dpp v40, v33, v40 quad_perm:[3,3,3,3] row_mask:0xf bank_mask:0xf
    v_add_f32_dpp v41, v37, v41 quad_perm:[3,3,3,3] row_mask:0xf bank_mask:0xf
    v_cndmask_b32 v38, v38, v39, s[48:49]
    v_cndmask_b32 v40, v40, v41, s[48:49]
    v_cndmask_b32 v42, v38, v40, s[50:51]
    s_waitcnt vmcnt(9)
    s_cselect_b64 s[32:33], s[34:35], s[32:33]
    s_cselect_b64 s[54:55], -1, 0
    v_cndmask_b32 v1, v1, v2, s[54:55]
    global_load_dwordx4 v[90:93], v1, s[32:33] offset:-4096 nt
    s_waitcnt vmcnt(9)
    global_load_dwordx4 v[94:97], v1, s[32:33] offset:-3072 nt
    v_mfma_f32_16x16x32_bf16 v[22:25], v[106:109], v[10:13], 0
    v_mfma_f32_16x16x32_bf16 v[26:29], v[110:113], v[10:13], 0
    v_mfma_f32_16x16x32_bf16 v[30:33], v[114:117], v[10:13], 0
    v_mfma_f32_16x16x32_bf16 v[34:37], v[118:121], v[10:13], 0
    s_waitcnt vmcnt(9)
    global_load_dwordx4 v[98:101], v1, s[32:33] offset:-2048 nt
    v_mov_b64 v[66:67], v[70:71]
    v_mov_b64 v[68:69], v[72:73]
    v_mov_b64 v[70:71], v[74:75]
    v_mov_b64 v[72:73], v[76:77]
    v_mov_b32_dpp v38, v22 quad_perm:[0,0,0,0] row_mask:0xf bank_mask:0xf
    v_mov_b32_dpp v39, v26 quad_perm:[0,0,0,0] row_mask:0xf bank_mask:0xf
    v_mov_b32_dpp v40, v30 quad_perm:[0,0,0,0] row_mask:0xf bank_mask:0xf
    v_mov_b32_dpp v41, v34 quad_perm:[0,0,0,0] row_mask:0xf bank_mask:0xf
    v_add_f32_dpp v38, v23, v38 quad_perm:[1,1,1,1] row_mask:0xf bank_mask:0xf
    v_add_f32_dpp v39, v27, v39 quad_perm:[1,1,1,1] row_mask:0xf bank_mask:0xf
    v_add_f32_dpp v40, v31, v40 quad_perm:[1,1,1,1] row_mask:0xf bank_mask:0xf
    v_add_f32_dpp v41, v35, v41 quad_perm:[1,1,1,1] row_mask:0xf bank_mask:0xf
    s_waitcnt vmcnt(9)
    global_load_dwordx4 v[102:105], v1, s[32:33] offset:-1024 nt
    v_add_f32_dpp v38, v24, v38 quad_perm:[2,2,2,2] row_mask:0xf bank_mask:0xf
    v_add_f32_dpp v39, v28, v39 quad_perm:[2,2,2,2] row_mask:0xf bank_mask:0xf
    v_add_f32_dpp v40, v32, v40 quad_perm:[2,2,2,2] row_mask:0xf bank_mask:0xf
    v_add_f32_dpp v41, v36, v41 quad_perm:[2,2,2,2] row_mask:0xf bank_mask:0xf
    v_add_f32_dpp v38, v25, v38 quad_perm:[3,3,3,3] row_mask:0xf bank_mask:0xf
    v_add_f32_dpp v39, v29, v39 quad_perm:[3,3,3,3] row_mask:0xf bank_mask:0xf
    v_add_f32_dpp v40, v33, v40 quad_perm:[3,3,3,3] row_mask:0xf bank_mask:0xf
    v_add_f32_dpp v41, v37, v41 quad_perm:[3,3,3,3] row_mask:0xf bank_mask:0xf
    v_cndmask_b32 v38, v38, v39, s[48:49]
    v_cndmask_b32 v40, v40, v41, s[48:49]
    v_cndmask_b32 v43, v38, v40, s[50:51]
    v_max3_f32 v6, v6, v42, v43
    s_waitcnt vmcnt(9)
    global_load_dwordx4 v[106:109], v1, s[32:33] offset:0 nt
    s_waitcnt vmcnt(9)
    global_load_dwordx4 v[110:113], v1, s[32:33] offset:1024 nt
    v_mfma_f32_16x16x32_bf16 v[22:25], v[122:125], v[10:13], 0
    v_mfma_f32_16x16x32_bf16 v[26:29], v[126:129], v[10:13], 0
    v_mfma_f32_16x16x32_bf16 v[30:33], v[130:133], v[10:13], 0
    v_mfma_f32_16x16x32_bf16 v[34:37], v[134:137], v[10:13], 0
    s_waitcnt vmcnt(9)
    global_load_dwordx4 v[114:117], v1, s[32:33] offset:2048 nt
    v_mov_b64 v[74:75], v[78:79]
    v_mov_b64 v[76:77], v[80:81]
    v_mov_b64 v[78:79], v[82:83]
    v_mov_b64 v[80:81], v[84:85]
    v_mov_b32_dpp v38, v22 quad_perm:[0,0,0,0] row_mask:0xf bank_mask:0xf
    v_mov_b32_dpp v39, v26 quad_perm:[0,0,0,0] row_mask:0xf bank_mask:0xf
    v_mov_b32_dpp v40, v30 quad_perm:[0,0,0,0] row_mask:0xf bank_mask:0xf
    v_mov_b32_dpp v41, v34 quad_perm:[0,0,0,0] row_mask:0xf bank_mask:0xf
    v_add_f32_dpp v38, v23, v38 quad_perm:[1,1,1,1] row_mask:0xf bank_mask:0xf
    v_add_f32_dpp v39, v27, v39 quad_perm:[1,1,1,1] row_mask:0xf bank_mask:0xf
    v_add_f32_dpp v40, v31, v40 quad_perm:[1,1,1,1] row_mask:0xf bank_mask:0xf
    v_add_f32_dpp v41, v35, v41 quad_perm:[1,1,1,1] row_mask:0xf bank_mask:0xf
    s_waitcnt vmcnt(9)
    global_load_dwordx4 v[118:121], v1, s[32:33] offset:3072 nt
    v_add_u32 v1, 16384, v1
    v_add_f32_dpp v38, v24, v38 quad_perm:[2,2,2,2] row_mask:0xf bank_mask:0xf
    v_add_f32_dpp v39, v28, v39 quad_perm:[2,2,2,2] row_mask:0xf bank_mask:0xf
    v_add_f32_dpp v40, v32, v40 quad_perm:[2,2,2,2] row_mask:0xf bank_mask:0xf
    v_add_f32_dpp v41, v36, v41 quad_perm:[2,2,2,2] row_mask:0xf bank_mask:0xf
    v_add_f32_dpp v38, v25, v38 quad_perm:[3,3,3,3] row_mask:0xf bank_mask:0xf
    v_add_f32_dpp v39, v29, v39 quad_perm:[3,3,3,3] row_mask:0xf bank_mask:0xf
    v_add_f32_dpp v40, v33, v40 quad_perm:[3,3,3,3] row_mask:0xf bank_mask:0xf
    v_add_f32_dpp v41, v37, v41 quad_perm:[3,3,3,3] row_mask:0xf bank_mask:0xf
    v_cndmask_b32 v38, v38, v39, s[48:49]
    v_cndmask_b32 v40, v40, v41, s[48:49]
    v_cndmask_b32 v44, v38, v40, s[50:51]
    s_waitcnt vmcnt(9)
    global_load_dwordx4 v[122:125], v1, s[32:33] offset:-4096 nt
    s_waitcnt vmcnt(9)
    global_load_dwordx4 v[126:129], v1, s[32:33] offset:-3072 nt
    v_mfma_f32_16x16x32_bf16 v[22:25], v[138:141], v[10:13], 0
    v_mfma_f32_16x16x32_bf16 v[26:29], v[142:145], v[10:13], 0
    v_mfma_f32_16x16x32_bf16 v[30:33], v[146:149], v[10:13], 0
    v_mfma_f32_16x16x32_bf16 v[34:37], v[150:153], v[10:13], 0
    s_waitcnt vmcnt(9)
    global_load_dwordx4 v[130:133], v1, s[32:33] offset:-2048 nt
    v_mov_b64 v[82:83], v[86:87]
    v_mov_b64 v[84:85], v[88:89]
    s_nop 0
    v_mov_b32_dpp v38, v22 quad_perm:[0,0,0,0] row_mask:0xf bank_mask:0xf
    v_mov_b32_dpp v39, v26 quad_perm:[0,0,0,0] row_mask:0xf bank_mask:0xf
    v_mov_b32_dpp v40, v30 quad_perm:[0,0,0,0] row_mask:0xf bank_mask:0xf
    v_mov_b32_dpp v41, v34 quad_perm:[0,0,0,0] row_mask:0xf bank_mask:0xf
    v_add_f32_dpp v38, v23, v38 quad_perm:[1,1,1,1] row_mask:0xf bank_mask:0xf
    v_add_f32_dpp v39, v27, v39 quad_perm:[1,1,1,1] row_mask:0xf bank_mask:0xf
    v_add_f32_dpp v40, v31, v40 quad_perm:[1,1,1,1] row_mask:0xf bank_mask:0xf
    v_add_f32_dpp v41, v35, v41 quad_perm:[1,1,1,1] row_mask:0xf bank_mask:0xf
    s_waitcnt vmcnt(9)
    global_load_dwordx4 v[134:137], v1, s[32:33] offset:-1024 nt
    v_add_f32_dpp v38, v24, v38 quad_perm:[2,2,2,2] row_mask:0xf bank_mask:0xf
    v_add_f32_dpp v39, v28, v39 quad_perm:[2,2,2,2] row_mask:0xf bank_mask:0xf
    v_add_f32_dpp v40, v32, v40 quad_perm:[2,2,2,2] row_mask:0xf bank_mask:0xf
    v_add_f32_dpp v41, v36, v41 quad_perm:[2,2,2,2] row_mask:0xf bank_mask:0xf
    v_add_f32_dpp v38, v25, v38 quad_perm:[3,3,3,3] row_mask:0xf bank_mask:0xf
    v_add_f32_dpp v39, v29, v39 quad_perm:[3,3,3,3] row_mask:0xf bank_mask:0xf
    v_add_f32_dpp v40, v33, v40 quad_perm:[3,3,3,3] row_mask:0xf bank_mask:0xf
    v_add_f32_dpp v41, v37, v41 quad_perm:[3,3,3,3] row_mask:0xf bank_mask:0xf
    v_cndmask_b32 v38, v38, v39, s[48:49]
    v_cndmask_b32 v40, v40, v41, s[48:49]
    v_cndmask_b32 v89, v38, v40, s[50:51]
    v_max3_f32 v6, v6, v44, v89
    v_mov_b64 v[86:87], v[42:43]
    v_mov_b32 v88, v44
    s_waitcnt vmcnt(9)
    global_load_dwordx4 v[138:141], v1, s[32:33] offset:0 nt
    s_sub_u32 s27, s27, 1
    s_cmp_lg_u32 s27, 0
    s_cbranch_scc1 L_kloop
    v_max_f32_dpp v6, v6, v6 quad_perm:[1,0,3,2] row_mask:0xf bank_mask:0xf
    s_nop 1
    v_max_f32_dpp v6, v6, v6 quad_perm:[2,3,0,1] row_mask:0xf bank_mask:0xf
    s_waitcnt vmcnt(9)
    global_load_dwordx4 v[142:145], v1, s[32:33] offset:1024 nt
    v_mov_b32 v5, v6
    s_nop 1
    v_permlane32_swap_b32 v6, v5
    v_max_f32 v6, v6, v5
    v_mov_b32 v5, v6
    s_nop 1
    v_permlane16_swap_b32 v6, v5
    v_max_f32 v6, v6, v5
    v_mul_f32 v7, s26, v6
    v_min_u32 v8, -2, v6
    s_waitcnt vmcnt(9)
    global_load_dwordx4 v[146:149], v1, s[32:33] offset:2048 nt
    v_fma_f32 v58, v58, s25, v7
    v_fma_f32 v59, v59, s25, v7
    v_exp_f32 v58, v58
    v_exp_f32 v59, v59
    s_nop 0
    v_mov_b64 v[46:47], v[58:59]
    v_cvt_pk_bf16_f32 v58, v58, v58
    v_cvt_pk_bf16_f32 v59, v59, v59
    s_waitcnt vmcnt(9)
    global_load_dwordx4 v[150:153], v1, s[32:33] offset:3072 nt
    v_add_u32 v1, 16384, v1
    v_and_b32_dpp v42, v58, v3 quad_perm:[0,0,0,0] row_mask:0xf bank_mask:0xf
    v_and_b32_dpp v43, v58, v4 quad_perm:[0,0,0,0] row_mask:0xf bank_mask:0xf
    v_and_b32_dpp v44, v58, v3 quad_perm:[1,1,1,1] row_mask:0xf bank_mask:0xf
    v_and_b32_dpp v45, v58, v4 quad_perm:[1,1,1,1] row_mask:0xf bank_mask:0xf
    v_mfma_f32_16x16x16_bf16 v[14:17], v[90:91], v[42:43], v[14:17]
    v_mfma_f32_16x16x16_bf16 v[18:21], v[92:93], v[42:43], v[18:21]
    s_waitcnt vmcnt(9)
    global_load_dwordx4 v[90:93], v1, s[32:33] offset:-4096 nt
    v_fma_f32 v60, v60, s25, v7
    v_fma_f32 v61, v61, s25, v7
    v_exp_f32 v60, v60
    v_exp_f32 v61, v61
    s_nop 0
    v_pk_add_f32 v[46:47], v[46:47], v[60:61]
    v_cvt_pk_bf16_f32 v60, v60, v60
    v_cvt_pk_bf16_f32 v61, v61, v61
    v_and_b32_dpp v42, v58, v3 quad_perm:[2,2,2,2] row_mask:0xf bank_mask:0xf
    v_and_b32_dpp v43, v58, v4 quad_perm:[2,2,2,2] row_mask:0xf bank_mask:0xf
    v_mfma_f32_16x16x16_bf16 v[14:17], v[94:95], v[44:45], v[14:17]
    v_mfma_f32_16x16x16_bf16 v[18:21], v[96:97], v[44:45], v[18:21]
    s_waitcnt vmcnt(9)
    global_load_dwordx4 v[94:97], v1, s[32:33] offset:-3072 nt
    v_fma_f32 v62, v62, s25, v7
    v_fma_f32 v63, v63, s25, v7
    v_exp_f32 v62, v62
    v_exp_f32 v63, v63
    s_nop 0
    v_pk_add_f32 v[46:47], v[46:47], v[62:63]
    v_cvt_pk_bf16_f32 v62, v62, v62
    v_cvt_pk_bf16_f32 v63, v63, v63
    v_and_b32_dpp v44, v58, v3 quad_perm:[3,3,3,3] row_mask:0xf bank_mask:0xf
    v_and_b32_dpp v45, v58, v4 quad_perm:[3,3,3,3] row_mask:0xf bank_mask:0xf
    v_mfma_f32_16x16x16_bf16 v[14:17], v[98:99], v[42:43], v[14:17]
    v_mfma_f32_16x16x16_bf16 v[18:21], v[100:101], v[42:43], v[18:21]
    s_waitcnt vmcnt(9)
    global_load_dwordx4 v[98:101], v1, s[32:33] offset:-2048 nt
    v_fma_f32 v64, v64, s25, v7
    v_fma_f32 v65, v65, s25, v7
    v_exp_f32 v64, v64
    v_exp_f32 v65, v65
    s_nop 0
    v_pk_add_f32 v[46:47], v[46:47], v[64:65]
    v_cvt_pk_bf16_f32 v64, v64, v64
    v_cvt_pk_bf16_f32 v65, v65, v65
    v_and_b32_dpp v42, v59, v3 quad_perm:[0,0,0,0] row_mask:0xf bank_mask:0xf
    v_and_b32_dpp v43, v59, v4 quad_perm:[0,0,0,0] row_mask:0xf bank_mask:0xf
    v_mfma_f32_16x16x16_bf16 v[14:17], v[102:103], v[44:45], v[14:17]
    v_mfma_f32_16x16x16_bf16 v[18:21], v[104:105], v[44:45], v[18:21]
    s_waitcnt vmcnt(9)
    global_load_dwordx4 v[102:105], v1, s[32:33] offset:-1024 nt
    v_fma_f32 v66, v66, s25, v7
    v_fma_f32 v67, v67, s25, v7
    v_exp_f32 v66, v66
    v_exp_f32 v67, v67
    s_nop 0
    v_pk_add_f32 v[46:47], v[46:47], v[66:67]
    v_cvt_pk_bf16_f32 v66, v66, v66
    v_cvt_pk_bf16_f32 v67, v67, v67
    v_and_b32_dpp v44, v59, v3 quad_perm:[1,1,1,1] row_mask:0xf bank_mask:0xf
    v_and_b32_dpp v45, v59, v4 quad_perm:[1,1,1,1] row_mask:0xf bank_mask:0xf
    v_mfma_f32_16x16x16_bf16 v[14:17], v[106:107], v[42:43], v[14:17]
    v_mfma_f32_16x16x16_bf16 v[18:21], v[108:109], v[42:43], v[18:21]
    s_waitcnt vmcnt(9)
    global_load_dwordx4 v[106:109], v1, s[32:33] offset:0 nt
    v_fma_f32 v68, v68, s25, v7
    v_fma_f32 v69, v69, s25, v7
    v_exp_f32 v68, v68
    v_exp_f32 v69, v69
    s_nop 0
    v_pk_add_f32 v[46:47], v[46:47], v[68:69]
    v_cvt_pk_bf16_f32 v68, v68, v68
    v_cvt_pk_bf16_f32 v69, v69, v69
    v_and_b32_dpp v42, v59, v3 quad_perm:[2,2,2,2] row_mask:0xf bank_mask:0xf
    v_and_b32_dpp v43, v59, v4 quad_perm:[2,2,2,2] row_mask:0xf bank_mask:0xf
    v_mfma_f32_16x16x16_bf16 v[14:17], v[110:111], v[44:45], v[14:17]
    v_mfma_f32_16x16x16_bf16 v[18:21], v[112:113], v[44:45], v[18:21]
    s_waitcnt vmcnt(9)
    global_load_dwordx4 v[110:113], v1, s[32:33] offset:1024 nt
    v_fma_f32 v70, v70, s25, v7
    v_fma_f32 v71, v71, s25, v7
    v_exp_f32 v70, v70
    v_exp_f32 v71, v71
    s_nop 0
    v_pk_add_f32 v[46:47], v[46:47], v[70:71]
    v_cvt_pk_bf16_f32 v70, v70, v70
    v_cvt_pk_bf16_f32 v71, v71, v71
    v_and_b32_dpp v44, v59, v3 quad_perm:[3,3,3,3] row_mask:0xf bank_mask:0xf
    v_and_b32_dpp v45, v59, v4 quad_perm:[3,3,3,3] row_mask:0xf bank_mask:0xf
    v_mfma_f32_16x16x16_bf16 v[14:17], v[114:115], v[42:43], v[14:17]
    v_mfma_f32_16x16x16_bf16 v[18:21], v[116:117], v[42:43], v[18:21]
    s_waitcnt vmcnt(9)
    global_load_dwordx4 v[114:117], v1, s[32:33] offset:2048 nt
    v_fma_f32 v72, v72, s25, v7
    v_fma_f32 v73, v73, s25, v7
    v_exp_f32 v72, v72
    v_exp_f32 v73, v73
    s_nop 0
    v_pk_add_f32 v[46:47], v[46:47], v[72:73]
    v_cvt_pk_bf16_f32 v72, v72, v72
    v_cvt_pk_bf16_f32 v73, v73, v73
    v_and_b32_dpp v42, v60, v3 quad_perm:[0,0,0,0] row_mask:0xf bank_mask:0xf
    v_and_b32_dpp v43, v60, v4 quad_perm:[0,0,0,0] row_mask:0xf bank_mask:0xf
    v_mfma_f32_16x16x16_bf16 v[14:17], v[118:119], v[44:45], v[14:17]
    v_mfma_f32_16x16x16_bf16 v[18:21], v[120:121], v[44:45], v[18:21]
    s_waitcnt vmcnt(9)
    global_load_dwordx4 v[118:121], v1, s[32:33] offset:3072 nt
    v_add_u32 v1, 16384, v1
    v_fma_f32 v74, v74, s25, v7
    v_fma_f32 v75, v75, s25, v7
    v_exp_f32 v74, v74
    v_exp_f32 v75, v75
    s_nop 0
    v_pk_add_f32 v[46:47], v[46:47], v[74:75]
    v_cvt_pk_bf16_f32 v74, v74, v74
    v_cvt_pk_bf16_f32 v75, v75, v75
    v_and_b32_dpp v44, v60, v3 quad_perm:[1,1,1,1] row_mask:0xf bank_mask:0xf
    v_and_b32_dpp v45, v60, v4 quad_perm:[1,1,1,1] row_mask:0xf bank_mask:0xf
    v_mfma_f32_16x16x16_bf16 v[14:17], v[122:123], v[42:43], v[14:17]
    v_mfma_f32_16x16x16_bf16 v[18:21], v[124:125], v[42:43], v[18:21]
    s_waitcnt vmcnt(9)
    global_load_dwordx4 v[122:125], v1, s[32:33] offset:-4096 nt
    v_fma_f32 v76, v76, s25, v7
    v_fma_f32 v77, v77, s25, v7
    v_exp_f32 v76, v76
    v_exp_f32 v77, v77
    s_nop 0
    v_pk_add_f32 v[46:47], v[46:47], v[76:77]
    v_cvt_pk_bf16_f32 v76, v76, v76
    v_cvt_pk_bf16_f32 v77, v77, v77
    v_and_b32_dpp v42, v60, v3 quad_perm:[2,2,2,2] row_mask:0xf bank_mask:0xf
    v_and_b32_dpp v43, v60, v4 quad_perm:[2,2,2,2] row_mask:0xf bank_mask:0xf
    v_mfma_f32_16x16x16_bf16 v[14:17], v[126:127], v[44:45], v[14:17]
    v_mfma_f32_16x16x16_bf16 v[18:21], v[128:129], v[44:45], v[18:21]
    s_waitcnt vmcnt(9)
    global_load_dwordx4 v[126:129], v1, s[32:33] offset:-3072 nt
    v_fma_f32 v78, v78, s25, v7
    v_fma_f32 v79, v79, s25, v7
    v_exp_f32 v78, v78
    v_exp_f32 v79, v79
    s_nop 0
    v_pk_add_f32 v[46:47], v[46:47], v[78:79]
    v_cvt_pk_bf16_f32 v78, v78, v78
    v_cvt_pk_bf16_f32 v79, v79, v79
    v_and_b32_dpp v44, v60, v3 quad_perm:[3,3,3,3] row_mask:0xf bank_mask:0xf
    v_and_b32_dpp v45, v60, v4 quad_perm:[3,3,3,3] row_mask:0xf bank_mask:0xf
    v_mfma_f32_16x16x16_bf16 v[14:17], v[130:131], v[42:43], v[14:17]
    v_mfma_f32_16x16x16_bf16 v[18:21], v[132:133], v[42:43], v[18:21]
    s_waitcnt vmcnt(9)
    global_load_dwordx4 v[130:133], v1, s[32:33] offset:-2048 nt
    v_fma_f32 v80, v80, s25, v7
    v_fma_f32 v81, v81, s25, v7
    v_exp_f32 v80, v80
    v_exp_f32 v81, v81
    s_nop 0
    v_pk_add_f32 v[46:47], v[46:47], v[80:81]
    v_cvt_pk_bf16_f32 v80, v80, v80
    v_cvt_pk_bf16_f32 v81, v81, v81
    v_and_b32_dpp v42, v61, v3 quad_perm:[0,0,0,0] row_mask:0xf bank_mask:0xf
    v_and_b32_dpp v43, v61, v4 quad_perm:[0,0,0,0] row_mask:0xf bank_mask:0xf
    v_mfma_f32_16x16x16_bf16 v[14:17], v[134:135], v[44:45], v[14:17]
    v_mfma_f32_16x16x16_bf16 v[18:21], v[136:137], v[44:45], v[18:21]
    s_waitcnt vmcnt(9)
    global_load_dwordx4 v[134:137], v1, s[32:33] offset:-1024 nt
    v_fma_f32 v82, v82, s25, v7
    v_fma_f32 v83, v83, s25, v7
    v_exp_f32 v82, v82
    v_exp_f32 v83, v83
    s_nop 0
    v_pk_add_f32 v[46:47], v[46:47], v[82:83]
    v_cvt_pk_bf16_f32 v82, v82, v82
    v_cvt_pk_bf16_f32 v83, v83, v83
    v_and_b32_dpp v44, v61, v3 quad_perm:[1,1,1,1] row_mask:0xf bank_mask:0xf
    v_and_b32_dpp v45, v61, v4 quad_perm:[1,1,1,1] row_mask:0xf bank_mask:0xf
    v_mfma_f32_16x16x16_bf16 v[14:17], v[138:139], v[42:43], v[14:17]
    v_mfma_f32_16x16x16_bf16 v[18:21], v[140:141], v[42:43], v[18:21]
    s_waitcnt vmcnt(9)
    global_load_dwordx4 v[138:141], v1, s[32:33] offset:0 nt
    v_fma_f32 v84, v84, s25, v7
    v_fma_f32 v85, v85, s25, v7
    v_exp_f32 v84, v84
    v_exp_f32 v85, v85
    s_nop 0
    v_pk_add_f32 v[46:47], v[46:47], v[84:85]
    v_cvt_pk_bf16_f32 v84, v84, v84
    v_cvt_pk_bf16_f32 v85, v85, v85
    v_and_b32_dpp v42, v61, v3 quad_perm:[2,2,2,2] row_mask:0xf bank_mask:0xf
    v_and_b32_dpp v43, v61, v4 quad_perm:[2,2,2,2] row_mask:0xf bank_mask:0xf
    v_mfma_f32_16x16x16_bf16 v[14:17], v[142:143], v[44:45], v[14:17]
    v_mfma_f32_16x16x16_bf16 v[18:21], v[144:145], v[44:45], v[18:21]
    s_waitcnt vmcnt(9)
    global_load_dwordx4 v[142:145], v1, s[32:33] offset:1024 nt
    v_fma_f32 v86, v86, s25, v7
    v_fma_f32 v87, v87, s25, v7
    v_exp_f32 v86, v86
    v_exp_f32 v87, v87
    s_nop 0
    v_pk_add_f32 v[46:47], v[46:47], v[86:87]
    v_cvt_pk_bf16_f32 v86, v86, v86
    v_cvt_pk_bf16_f32 v87, v87, v87
    v_and_b32_dpp v44, v61, v3 quad_perm:[3,3,3,3] row_mask:0xf bank_mask:0xf
    v_and_b32_dpp v45, v61, v4 quad_perm:[3,3,3,3] row_mask:0xf bank_mask:0xf
    v_mfma_f32_16x16x16_bf16 v[14:17], v[146:147], v[42:43], v[14:17]
    v_mfma_f32_16x16x16_bf16 v[18:21], v[148:149], v[42:43], v[18:21]
    s_waitcnt vmcnt(9)
    global_load_dwordx4 v[146:149], v1, s[32:33] offset:2048 nt
    v_fma_f32 v88, v88, s25, v7
    v_fma_f32 v89, v89, s25, v7
    v_exp_f32 v88, v88
    v_exp_f32 v89, v89
    s_nop 0
    v_pk_add_f32 v[46:47], v[46:47], v[88:89]
    v_cvt_pk_bf16_f32 v88, v88, v88
    v_cvt_pk_bf16_f32 v89, v89, v89
    v_and_b32_dpp v42, v62, v3 quad_perm:[0,0,0,0] row_mask:0xf bank_mask:0xf
    v_and_b32_dpp v43, v62, v4 quad_perm:[0,0,0,0] row_mask:0xf bank_mask:0xf
    v_mfma_f32_16x16x16_bf16 v[14:17], v[150:151], v[44:45], v[14:17]
    v_mfma_f32_16x16x16_bf16 v[18:21], v[152:153], v[44:45], v[18:21]
    s_waitcnt vmcnt(9)
    global_load_dwordx4 v[150:153], v1, s[32:33] offset:3072 nt
    v_add_u32 v1, 16384, v1
    v_add_f32 v9, v46, v47
    s_nop 1
    v_add_f32_dpp v9, v9, v9 quad_perm:[1,0,3,2] row_mask:0xf bank_mask:0xf
    s_nop 1
    v_add_f32_dpp v9, v9, v9 quad_perm:[2,3,0,1] row_mask:0xf bank_mask:0xf
    v_mov_b32 v5, v9
    s_nop 1
    v_permlane32_swap_b32 v9, v5
    v_add_f32 v9, v9, v5
    v_mov_b32 v5, v9
    s_nop 1
    v_permlane16_swap_b32 v9, v5
    v_add_f32 v9, v9, v5
    v_min_u32 v9, -2, v9
    ds_write_b64 v52, v[8:9] offset:0
    v_mov_b32 v7, 0
    v_and_b32_dpp v44, v62, v3 quad_perm:[1,1,1,1] row_mask:0xf bank_mask:0xf
    v_and_b32_dpp v45, v62, v4 quad_perm:[1,1,1,1] row_mask:0xf bank_mask:0xf
    v_mov_b64 v[58:59], v[62:63]
    v_mov_b64 v[60:61], v[64:65]
    v_mov_b64 v[62:63], v[66:67]
    v_mov_b64 v[64:65], v[68:69]
    v_mov_b64 v[66:67], v[70:71]
    v_mov_b64 v[68:69], v[72:73]
    v_mov_b64 v[70:71], v[74:75]
    v_mov_b64 v[72:73], v[76:77]
    v_mov_b64 v[74:75], v[78:79]
    v_mov_b64 v[76:77], v[80:81]
    v_mov_b64 v[78:79], v[82:83]
    v_mov_b64 v[80:81], v[84:85]
    v_mov_b64 v[82:83], v[86:87]
    v_mov_b64 v[84:85], v[88:89]
    s_mov_b32 s27, 4
L_vloop:
    v_mfma_f32_16x16x16_bf16 v[14:17], v[90:91], v[42:43], v[14:17]
    v_mfma_f32_16x16x16_bf16 v[18:21], v[92:93], v[42:43], v[18:21]
    s_waitcnt vmcnt(9)
    global_load_dwordx4 v[90:93], v1, s[32:33] offset:-4096 nt
    v_and_b32_dpp v42, v58, v3 quad_perm:[2,2,2,2] row_mask:0xf bank_mask:0xf
    v_and_b32_dpp v43, v58, v4 quad_perm:[2,2,2,2] row_mask:0xf bank_mask:0xf
    v_mfma_f32_16x16x16_bf16 v[14:17], v[94:95], v[44:45], v[14:17]
    v_mfma_f32_16x16x16_bf16 v[18:21], v[96:97], v[44:45], v[18:21]
    s_waitcnt vmcnt(9)
    global_load_dwordx4 v[94:97], v1, s[32:33] offset:-3072 nt
    v_and_b32_dpp v44, v58, v3 quad_perm:[3,3,3,3] row_mask:0xf bank_mask:0xf
    v_and_b32_dpp v45, v58, v4 quad_perm:[3,3,3,3] row_mask:0xf bank_mask:0xf
    v_mfma_f32_16x16x16_bf16 v[14:17], v[98:99], v[42:43], v[14:17]
    v_mfma_f32_16x16x16_bf16 v[18:21], v[100:101], v[42:43], v[18:21]
    s_waitcnt vmcnt(9)
    global_load_dwordx4 v[98:101], v1, s[32:33] offset:-2048 nt
    v_and_b32_dpp v42, v59, v3 quad_perm:[0,0,0,0] row_mask:0xf bank_mask:0xf
    v_and_b32_dpp v43, v59, v4 quad_perm:[0,0,0,0] row_mask:0xf bank_mask:0xf
    v_mfma_f32_16x16x16_bf16 v[14:17], v[102:103], v[44:45], v[14:17]
    v_mfma_f32_16x16x16_bf16 v[18:21], v[104:105], v[44:45], v[18:21]
    s_waitcnt vmcnt(9)
    global_load_dwordx4 v[102:105], v1, s[32:33] offset:-1024 nt
    v_and_b32_dpp v44, v59, v3 quad_perm:[1,1,1,1] row_mask:0xf bank_mask:0xf
    v_and_b32_dpp v45, v59, v4 quad_perm:[1,1,1,1] row_mask:0xf bank_mask:0xf
    v_mfma_f32_16x16x16_bf16 v[14:17], v[106:107], v[42:43], v[14:17]
    v_mfma_f32_16x16x16_bf16 v[18:21], v[108:109], v[42:43], v[18:21]
    s_waitcnt vmcnt(9)
    global_load_dwordx4 v[106:109], v1, s[32:33] offset:0 nt
    v_and_b32_dpp v42, v59, v3 quad_perm:[2,2,2,2] row_mask:0xf bank_mask:0xf
    v_and_b32_dpp v43, v59, v4 quad_perm:[2,2,2,2] row_mask:0xf bank_mask:0xf
    v_mfma_f32_16x16x16_bf16 v[14:17], v[110:111], v[44:45], v[14:17]
    v_mfma_f32_16x16x16_bf16 v[18:21], v[112:113], v[44:45], v[18:21]
    s_waitcnt vmcnt(9)
    global_load_dwordx4 v[110:113], v1, s[32:33] offset:1024 nt
    v_and_b32_dpp v44, v59, v3 quad_perm:[3,3,3,3] row_mask:0xf bank_mask:0xf
    v_and_b32_dpp v45, v59, v4 quad_perm:[3,3,3,3] row_mask:0xf bank_mask:0xf
    v_mfma_f32_16x16x16_bf16 v[14:17], v[114:115], v[42:43], v[14:17]
    v_mfma_f32_16x16x16_bf16 v[18:21], v[116:117], v[42:43], v[18:21]
    s_waitcnt vmcnt(9)
    global_load_dwordx4 v[114:117], v1, s[32:33] offset:2048 nt
    v_and_b32_dpp v42, v60, v3 quad_perm:[0,0,0,0] row_mask:0xf bank_mask:0xf
    v_and_b32_dpp v43, v60, v4 quad_perm:[0,0,0,0] row_mask:0xf bank_mask:0xf
    v_mfma_f32_16x16x16_bf16 v[14:17], v[118:119], v[44:45], v[14:17]
    v_mfma_f32_16x16x16_bf16 v[18:21], v[120:121], v[44:45], v[18:21]
    s_waitcnt vmcnt(9)
    global_load_dwordx4 v[118:121], v1, s[32:33] offset:3072 nt
    v_add_u32 v1, 16384, v1
    v_and_b32_dpp v44, v60, v3 quad_perm:[1,1,1,1] row_mask:0xf bank_mask:0xf
    v_and_b32_dpp v45, v60, v4 quad_perm:[1,1,1,1] row_mask:0xf bank_mask:0xf
    v_mfma_f32_16x16x16_bf16 v[14:17], v[122:123], v[42:43], v[14:17]
    v_mfma_f32_16x16x16_bf16 v[18:21], v[124:125], v[42:43], v[18:21]
    s_waitcnt vmcnt(9)
    global_load_dwordx4 v[122:125], v1, s[32:33] offset:-4096 nt
    v_and_b32_dpp v42, v60, v3 quad_perm:[2,2,2,2] row_mask:0xf bank_mask:0xf
    v_and_b32_dpp v43, v60, v4 quad_perm:[2,2,2,2] row_mask:0xf bank_mask:0xf
    v_mfma_f32_16x16x16_bf16 v[14:17], v[126:127], v[44:45], v[14:17]
    v_mfma_f32_16x16x16_bf16 v[18:21], v[128:129], v[44:45], v[18:21]
    s_waitcnt vmcnt(9)
    global_load_dwordx4 v[126:129], v1, s[32:33] offset:-3072 nt
    v_and_b32_dpp v44, v60, v3 quad_perm:[3,3,3,3] row_mask:0xf bank_mask:0xf
    v_and_b32_dpp v45, v60, v4 quad_perm:[3,3,3,3] row_mask:0xf bank_mask:0xf
    v_mfma_f32_16x16x16_bf16 v[14:17], v[130:131], v[42:43], v[14:17]
    v_mfma_f32_16x16x16_bf16 v[18:21], v[132:133], v[42:43], v[18:21]
    s_waitcnt vmcnt(9)
    global_load_dwordx4 v[130:133], v1, s[32:33] offset:-2048 nt
    v_and_b32_dpp v42, v61, v3 quad_perm:[0,0,0,0] row_mask:0xf bank_mask:0xf
    v_and_b32_dpp v43, v61, v4 quad_perm:[0,0,0,0] row_mask:0xf bank_mask:0xf
    v_mfma_f32_16x16x16_bf16 v[14:17], v[134:135], v[44:45], v[14:17]
    v_mfma_f32_16x16x16_bf16 v[18:21], v[136:137], v[44:45], v[18:21]
    s_waitcnt vmcnt(9)
    global_load_dwordx4 v[134:137], v1, s[32:33] offset:-1024 nt
    v_and_b32_dpp v44, v61, v3 quad_perm:[1,1,1,1] row_mask:0xf bank_mask:0xf
    v_and_b32_dpp v45, v61, v4 quad_perm:[1,1,1,1] row_mask:0xf bank_mask:0xf
    v_mfma_f32_16x16x16_bf16 v[14:17], v[138:139], v[42:43], v[14:17]
    v_mfma_f32_16x16x16_bf16 v[18:21], v[140:141], v[42:43], v[18:21]
    s_waitcnt vmcnt(9)
    global_load_dwordx4 v[138:141], v1, s[32:33] offset:0 nt
    v_and_b32_dpp v42, v61, v3 quad_perm:[2,2,2,2] row_mask:0xf bank_mask:0xf
    v_and_b32_dpp v43, v61, v4 quad_perm:[2,2,2,2] row_mask:0xf bank_mask:0xf
    v_mfma_f32_16x16x16_bf16 v[14:17], v[142:143], v[44:45], v[14:17]
    v_mfma_f32_16x16x16_bf16 v[18:21], v[144:145], v[44:45], v[18:21]
    s_waitcnt vmcnt(9)
    global_load_dwordx4 v[142:145], v1, s[32:33] offset:1024 nt
    v_and_b32_dpp v44, v61, v3 quad_perm:[3,3,3,3] row_mask:0xf bank_mask:0xf
    v_and_b32_dpp v45, v61, v4 quad_perm:[3,3,3,3] row_mask:0xf bank_mask:0xf
    v_mfma_f32_16x16x16_bf16 v[14:17], v[146:147], v[42:43], v[14:17]
    v_mfma_f32_16x16x16_bf16 v[18:21], v[148:149], v[42:43], v[18:21]
    s_waitcnt vmcnt(9)
    global_load_dwordx4 v[146:149], v1, s[32:33] offset:2048 nt
    v_and_b32_dpp v42, v62, v3 quad_perm:[0,0,0,0] row_mask:0xf bank_mask:0xf
    v_and_b32_dpp v43, v62, v4 quad_perm:[0,0,0,0] row_mask:0xf bank_mask:0xf
    v_mfma_f32_16x16x16_bf16 v[14:17], v[150:151], v[44:45], v[14:17]
    v_mfma_f32_16x16x16_bf16 v[18:21], v[152:153], v[44:45], v[18:21]
    s_waitcnt vmcnt(9)
    global_load_dwordx4 v[150:153], v1, s[32:33] offset:3072 nt
    v_add_u32 v1, 16384, v1
    v_and_b32_dpp v44, v62, v3 quad_perm:[1,1,1,1] row_mask:0xf bank_mask:0xf
    v_and_b32_dpp v45, v62, v4 quad_perm:[1,1,1,1] row_mask:0xf bank_mask:0xf
    v_mov_b64 v[58:59], v[62:63]
    v_mov_b64 v[60:61], v[64:65]
    v_mov_b64 v[62:63], v[66:67]
    v_mov_b64 v[64:65], v[68:69]
    v_mov_b64 v[66:67], v[70:71]
    v_mov_b64 v[68:69], v[72:73]
    v_mov_b64 v[70:71], v[74:75]
    v_mov_b64 v[72:73], v[76:77]
    v_mov_b64 v[74:75], v[78:79]
    v_mov_b64 v[76:77], v[80:81]
    v_mov_b64 v[78:79], v[82:83]
    v_mov_b64 v[80:81], v[84:85]
    s_sub_u32 s27, s27, 1
    s_cmp_lg_u32 s27, 0
    s_cbranch_scc1 L_vloop
    s_mov_b32 s27, 2
L_dloop:
    s_waitcnt vmcnt(15)
    v_mfma_f32_16x16x16_bf16 v[14:17], v[90:91], v[42:43], v[14:17]
    v_mfma_f32_16x16x16_bf16 v[18:21], v[92:93], v[42:43], v[18:21]
    global_load_dwordx4 v[90:93], v1, s[32:33] offset:-4096 nt
    v_and_b32_dpp v42, v58, v3 quad_perm:[2,2,2,2] row_mask:0xf bank_mask:0xf
    v_and_b32_dpp v43, v58, v4 quad_perm:[2,2,2,2] row_mask:0xf bank_mask:0xf
    s_waitcnt vmcnt(15)
    v_mfma_f32_16x16x16_bf16 v[14:17], v[94:95], v[44:45], v[14:17]
    v_mfma_f32_16x16x16_bf16 v[18:21], v[96:97], v[44:45], v[18:21]
    global_load_dwordx4 v[94:97], v1, s[32:33] offset:-3072 nt
    v_and_b32_dpp v44, v58, v3 quad_perm:[3,3,3,3] row_mask:0xf bank_mask:0xf
    v_and_b32_dpp v45, v58, v4 quad_perm:[3,3,3,3] row_mask:0xf bank_mask:0xf
    s_waitcnt vmcnt(15)
    v_mfma_f32_16x16x16_bf16 v[14:17], v[98:99], v[42:43], v[14:17]
    v_mfma_f32_16x16x16_bf16 v[18:21], v[100:101], v[42:43], v[18:21]
    global_load_dwordx4 v[98:101], v1, s[32:33] offset:-2048 nt
    v_and_b32_dpp v42, v59, v3 quad_perm:[0,0,0,0] row_mask:0xf bank_mask:0xf
    v_and_b32_dpp v43, v59, v4 quad_perm:[0,0,0,0] row_mask:0xf bank_mask:0xf
    s_waitcnt vmcnt(15)
    v_mfma_f32_16x16x16_bf16 v[14:17], v[102:103], v[44:45], v[14:17]
    v_mfma_f32_16x16x16_bf16 v[18:21], v[104:105], v[44:45], v[18:21]
    global_load_dwordx4 v[102:105], v1, s[32:33] offset:-1024 nt
    v_and_b32_dpp v44, v59, v3 quad_perm:[1,1,1,1] row_mask:0xf bank_mask:0xf
    v_and_b32_dpp v45, v59, v4 quad_perm:[1,1,1,1] row_mask:0xf bank_mask:0xf
    s_waitcnt vmcnt(15)
    v_mfma_f32_16x16x16_bf16 v[14:17], v[106:107], v[42:43], v[14:17]
    v_mfma_f32_16x16x16_bf16 v[18:21], v[108:109], v[42:43], v[18:21]
    global_load_dwordx4 v[106:109], v1, s[32:33] offset:0 nt
    v_and_b32_dpp v42, v59, v3 quad_perm:[2,2,2,2] row_mask:0xf bank_mask:0xf
    v_and_b32_dpp v43, v59, v4 quad_perm:[2,2,2,2] row_mask:0xf bank_mask:0xf
    s_waitcnt vmcnt(15)
    v_mfma_f32_16x16x16_bf16 v[14:17], v[110:111], v[44:45], v[14:17]
    v_mfma_f32_16x16x16_bf16 v[18:21], v[112:113], v[44:45], v[18:21]
    global_load_dwordx4 v[110:113], v1, s[32:33] offset:1024 nt
    v_and_b32_dpp v44, v59, v3 quad_perm:[3,3,3,3] row_mask:0xf bank_mask:0xf
    v_and_b32_dpp v45, v59, v4 quad_perm:[3,3,3,3] row_mask:0xf bank_mask:0xf
    s_waitcnt vmcnt(15)
    v_mfma_f32_16x16x16_bf16 v[14:17], v[114:115], v[42:43], v[14:17]
    v_mfma_f32_16x16x16_bf16 v[18:21], v[116:117], v[42:43], v[18:21]
    global_load_dwordx4 v[114:117], v1, s[32:33] offset:2048 nt
    v_and_b32_dpp v42, v60, v3 quad_perm:[0,0,0,0] row_mask:0xf bank_mask:0xf
    v_and_b32_dpp v43, v60, v4 quad_perm:[0,0,0,0] row_mask:0xf bank_mask:0xf
    s_waitcnt vmcnt(15)
    v_mfma_f32_16x16x16_bf16 v[14:17], v[118:119], v[44:45], v[14:17]
    v_mfma_f32_16x16x16_bf16 v[18:21], v[120:121], v[44:45], v[18:21]
    global_load_dwordx4 v[118:121], v1, s[32:33] offset:3072 nt
    v_add_u32 v1, 16384, v1
    v_and_b32_dpp v44, v60, v3 quad_perm:[1,1,1,1] row_mask:0xf bank_mask:0xf
    v_and_b32_dpp v45, v60, v4 quad_perm:[1,1,1,1] row_mask:0xf bank_mask:0xf
    s_waitcnt vmcnt(15)
    v_mfma_f32_16x16x16_bf16 v[14:17], v[122:123], v[42:43], v[14:17]
    v_mfma_f32_16x16x16_bf16 v[18:21], v[124:125], v[42:43], v[18:21]
    global_load_dwordx4 v[122:125], v1, s[32:33] offset:-4096 nt
    v_and_b32_dpp v42, v60, v3 quad_perm:[2,2,2,2] row_mask:0xf bank_mask:0xf
    v_and_b32_dpp v43, v60, v4 quad_perm:[2,2,2,2] row_mask:0xf bank_mask:0xf
    s_waitcnt vmcnt(15)
    v_mfma_f32_16x16x16_bf16 v[14:17], v[126:127], v[44:45], v[14:17]
    v_mfma_f32_16x16x16_bf16 v[18:21], v[128:129], v[44:45], v[18:21]
    global_load_dwordx4 v[126:129], v1, s[32:33] offset:-3072 nt
    v_and_b32_dpp v44, v60, v3 quad_perm:[3,3,3,3] row_mask:0xf bank_mask:0xf
    v_and_b32_dpp v45, v60, v4 quad_perm:[3,3,3,3] row_mask:0xf bank_mask:0xf
    s_waitcnt vmcnt(15)
    v_mfma_f32_16x16x16_bf16 v[14:17], v[130:131], v[42:43], v[14:17]
    v_mfma_f32_16x16x16_bf16 v[18:21], v[132:133], v[42:43], v[18:21]
    global_load_dwordx4 v[130:133], v1, s[32:33] offset:-2048 nt
    v_and_b32_dpp v42, v61, v3 quad_perm:[0,0,0,0] row_mask:0xf bank_mask:0xf
    v_and_b32_dpp v43, v61, v4 quad_perm:[0,0,0,0] row_mask:0xf bank_mask:0xf
    s_waitcnt vmcnt(15)
    v_mfma_f32_16x16x16_bf16 v[14:17], v[134:135], v[44:45], v[14:17]
    v_mfma_f32_16x16x16_bf16 v[18:21], v[136:137], v[44:45], v[18:21]
    global_load_dwordx4 v[134:137], v1, s[32:33] offset:-1024 nt
    v_and_b32_dpp v44, v61, v3 quad_perm:[1,1,1,1] row_mask:0xf bank_mask:0xf
    v_and_b32_dpp v45, v61, v4 quad_perm:[1,1,1,1] row_mask:0xf bank_mask:0xf
    s_waitcnt vmcnt(15)
    v_mfma_f32_16x16x16_bf16 v[14:17], v[138:139], v[42:43], v[14:17]
    v_mfma_f32_16x16x16_bf16 v[18:21], v[140:141], v[42:43], v[18:21]
    global_load_dwordx4 v[138:141], v1, s[32:33] offset:0 nt
    v_and_b32_dpp v42, v61, v3 quad_perm:[2,2,2,2] row_mask:0xf bank_mask:0xf
    v_and_b32_dpp v43, v61, v4 quad_perm:[2,2,2,2] row_mask:0xf bank_mask:0xf
    s_waitcnt vmcnt(15)
    v_mfma_f32_16x16x16_bf16 v[14:17], v[142:143], v[44:45], v[14:17]
    v_mfma_f32_16x16x16_bf16 v[18:21], v[144:145], v[44:45], v[18:21]
    global_load_dwordx4 v[142:145], v1, s[32:33] offset:1024 nt
    v_and_b32_dpp v44, v61, v3 quad_perm:[3,3,3,3] row_mask:0xf bank_mask:0xf
    v_and_b32_dpp v45, v61, v4 quad_perm:[3,3,3,3] row_mask:0xf bank_mask:0xf
    s_waitcnt vmcnt(15)
    v_mfma_f32_16x16x16_bf16 v[14:17], v[146:147], v[42:43], v[14:17]
    v_mfma_f32_16x16x16_bf16 v[18:21], v[148:149], v[42:43], v[18:21]
    global_load_dwordx4 v[146:149], v1, s[32:33] offset:2048 nt
    v_and_b32_dpp v42, v62, v3 quad_perm:[0,0,0,0] row_mask:0xf bank_mask:0xf
    v_and_b32_dpp v43, v62, v4 quad_perm:[0,0,0,0] row_mask:0xf bank_mask:0xf
    s_waitcnt vmcnt(15)
    v_mfma_f32_16x16x16_bf16 v[14:17], v[150:151], v[44:45], v[14:17]
    v_mfma_f32_16x16x16_bf16 v[18:21], v[152:153], v[44:45], v[18:21]
    global_load_dwordx4 v[150:153], v1, s[32:33] offset:3072 nt
    v_add_u32 v1, 16384, v1
    v_and_b32_dpp v44, v62, v3 quad_perm:[1,1,1,1] row_mask:0xf bank_mask:0xf
    v_and_b32_dpp v45, v62, v4 quad_perm:[1,1,1,1] row_mask:0xf bank_mask:0xf
    v_mov_b64 v[58:59], v[62:63]
    v_mov_b64 v[60:61], v[64:65]
    v_mov_b64 v[62:63], v[66:67]
    v_mov_b64 v[64:65], v[68:69]
    s_sub_u32 s27, s27, 1
    s_cmp_lg_u32 s27, 0
    s_cbranch_scc1 L_dloop
L_beta:
    ds_read_b64 v[56:57], v50 offset:1024
    ds_read_b32 v5, v7 offset:4096
    s_waitcnt lgkmcnt(0)
    v_cmp_eq_u32 vcc, -1, v56
    s_cbranch_vccnz L_beta
    v_readfirstlane_b32 s52, v5
    s_waitcnt vmcnt(15)
    v_mfma_f32_16x16x16_bf16 v[14:17], v[90:91], v[42:43], v[14:17]
    v_mfma_f32_16x16x16_bf16 v[18:21], v[92:93], v[42:43], v[18:21]
    v_and_b32_dpp v42, v58, v3 quad_perm:[2,2,2,2] row_mask:0xf bank_mask:0xf
    v_and_b32_dpp v43, v58, v4 quad_perm:[2,2,2,2] row_mask:0xf bank_mask:0xf
    s_waitcnt vmcnt(14)
    v_mfma_f32_16x16x16_bf16 v[14:17], v[94:95], v[44:45], v[14:17]
    v_mfma_f32_16x16x16_bf16 v[18:21], v[96:97], v[44:45], v[18:21]
    v_and_b32_dpp v44, v58, v3 quad_perm:[3,3,3,3] row_mask:0xf bank_mask:0xf
    v_and_b32_dpp v45, v58, v4 quad_perm:[3,3,3,3] row_mask:0xf bank_mask:0xf
    s_waitcnt vmcnt(13)
    v_mfma_f32_16x16x16_bf16 v[14:17], v[98:99], v[42:43], v[14:17]
    v_mfma_f32_16x16x16_bf16 v[18:21], v[100:101], v[42:43], v[18:21]
    v_and_b32_dpp v42, v59, v3 quad_perm:[0,0,0,0] row_mask:0xf bank_mask:0xf
    v_and_b32_dpp v43, v59, v4 quad_perm:[0,0,0,0] row_mask:0xf bank_mask:0xf
    s_waitcnt vmcnt(12)
    v_mfma_f32_16x16x16_bf16 v[14:17], v[102:103], v[44:45], v[14:17]
    v_mfma_f32_16x16x16_bf16 v[18:21], v[104:105], v[44:45], v[18:21]
    v_and_b32_dpp v44, v59, v3 quad_perm:[1,1,1,1] row_mask:0xf bank_mask:0xf
    v_and_b32_dpp v45, v59, v4 quad_perm:[1,1,1,1] row_mask:0xf bank_mask:0xf
    s_waitcnt vmcnt(11)
    v_mfma_f32_16x16x16_bf16 v[14:17], v[106:107], v[42:43], v[14:17]
    v_mfma_f32_16x16x16_bf16 v[18:21], v[108:109], v[42:43], v[18:21]
    v_and_b32_dpp v42, v59, v3 quad_perm:[2,2,2,2] row_mask:0xf bank_mask:0xf
    v_and_b32_dpp v43, v59, v4 quad_perm:[2,2,2,2] row_mask:0xf bank_mask:0xf
    s_waitcnt vmcnt(10)
    v_mfma_f32_16x16x16_bf16 v[14:17], v[110:111], v[44:45], v[14:17]
    v_mfma_f32_16x16x16_bf16 v[18:21], v[112:113], v[44:45], v[18:21]
    v_and_b32_dpp v44, v59, v3 quad_perm:[3,3,3,3] row_mask:0xf bank_mask:0xf
    v_and_b32_dpp v45, v59, v4 quad_perm:[3,3,3,3] row_mask:0xf bank_mask:0xf
    s_waitcnt vmcnt(9)
    v_mfma_f32_16x16x16_bf16 v[14:17], v[114:115], v[42:43], v[14:17]
    v_mfma_f32_16x16x16_bf16 v[18:21], v[116:117], v[42:43], v[18:21]
    v_and_b32_dpp v42, v60, v3 quad_perm:[0,0,0,0] row_mask:0xf bank_mask:0xf
    v_and_b32_dpp v43, v60, v4 quad_perm:[0,0,0,0] row_mask:0xf bank_mask:0xf
    s_waitcnt vmcnt(8)
    v_mfma_f32_16x16x16_bf16 v[14:17], v[118:119], v[44:45], v[14:17]
    v_mfma_f32_16x16x16_bf16 v[18:21], v[120:121], v[44:45], v[18:21]
    v_and_b32_dpp v44, v60, v3 quad_perm:[1,1,1,1] row_mask:0xf bank_mask:0xf
    v_and_b32_dpp v45, v60, v4 quad_perm:[1,1,1,1] row_mask:0xf bank_mask:0xf
    s_waitcnt vmcnt(7)
    v_mfma_f32_16x16x16_bf16 v[14:17], v[122:123], v[42:43], v[14:17]
    v_mfma_f32_16x16x16_bf16 v[18:21], v[124:125], v[42:43], v[18:21]
    v_and_b32_dpp v42, v60, v3 quad_perm:[2,2,2,2] row_mask:0xf bank_mask:0xf
    v_and_b32_dpp v43, v60, v4 quad_perm:[2,2,2,2] row_mask:0xf bank_mask:0xf
    s_waitcnt vmcnt(6)
    v_mfma_f32_16x16x16_bf16 v[14:17], v[126:127], v[44:45], v[14:17]
    v_mfma_f32_16x16x16_bf16 v[18:21], v[128:129], v[44:45], v[18:21]
    v_and_b32_dpp v44, v60, v3 quad_perm:[3,3,3,3] row_mask:0xf bank_mask:0xf
    v_and_b32_dpp v45, v60, v4 quad_perm:[3,3,3,3] row_mask:0xf bank_mask:0xf
    s_waitcnt vmcnt(5)
    v_mfma_f32_16x16x16_bf16 v[14:17], v[130:131], v[42:43], v[14:17]
    v_mfma_f32_16x16x16_bf16 v[18:21], v[132:133], v[42:43], v[18:21]
    v_and_b32_dpp v42, v61, v3 quad_perm:[0,0,0,0] row_mask:0xf bank_mask:0xf
    v_and_b32_dpp v43, v61, v4 quad_perm:[0,0,0,0] row_mask:0xf bank_mask:0xf
    s_waitcnt vmcnt(4)
    v_mfma_f32_16x16x16_bf16 v[14:17], v[134:135], v[44:45], v[14:17]
    v_mfma_f32_16x16x16_bf16 v[18:21], v[136:137], v[44:45], v[18:21]
    v_and_b32_dpp v44, v61, v3 quad_perm:[1,1,1,1] row_mask:0xf bank_mask:0xf
    v_and_b32_dpp v45, v61, v4 quad_perm:[1,1,1,1] row_mask:0xf bank_mask:0xf
    s_waitcnt vmcnt(3)
    v_mfma_f32_16x16x16_bf16 v[14:17], v[138:139], v[42:43], v[14:17]
    v_mfma_f32_16x16x16_bf16 v[18:21], v[140:141], v[42:43], v[18:21]
    v_and_b32_dpp v42, v61, v3 quad_perm:[2,2,2,2] row_mask:0xf bank_mask:0xf
    v_and_b32_dpp v43, v61, v4 quad_perm:[2,2,2,2] row_mask:0xf bank_mask:0xf
    s_waitcnt vmcnt(2)
    v_mfma_f32_16x16x16_bf16 v[14:17], v[142:143], v[44:45], v[14:17]
    v_mfma_f32_16x16x16_bf16 v[18:21], v[144:145], v[44:45], v[18:21]
    v_and_b32_dpp v44, v61, v3 quad_perm:[3,3,3,3] row_mask:0xf bank_mask:0xf
    v_and_b32_dpp v45, v61, v4 quad_perm:[3,3,3,3] row_mask:0xf bank_mask:0xf
    s_waitcnt vmcnt(1)
    v_mfma_f32_16x16x16_bf16 v[14:17], v[146:147], v[42:43], v[14:17]
    v_mfma_f32_16x16x16_bf16 v[18:21], v[148:149], v[42:43], v[18:21]
    s_cmp_eq_u32 s3, 0
    s_cbranch_scc1 L_x0
    s_cmp_eq_u32 s52, 0
    s_waitcnt vmcnt(0)
    v_mfma_f32_16x16x16_bf16 v[14:17], v[150:151], v[44:45], v[14:17]
    v_mfma_f32_16x16x16_bf16 v[18:21], v[152:153], v[44:45], v[18:21]
    s_nop 6
    ds_write_b128 v48, v[14:17] offset:2048
    v_pk_mul_f32 v[18:19], v[18:19], v[56:57] op_sel:[0,1] op_sel_hi:[1,1]
    v_pk_mul_f32 v[20:21], v[20:21], v[56:57] op_sel:[0,1] op_sel_hi:[1,1]
    s_waitcnt lgkmcnt(0)
    s_barrier
    ds_read_b128 v[22:25], v49 offset:2048
    s_waitcnt lgkmcnt(0)
    v_pk_fma_f32 v[22:23], v[22:23], v[56:57], v[18:19] op_sel_hi:[1,0,1]
    v_pk_fma_f32 v[24:25], v[24:25], v[56:57], v[20:21] op_sel_hi:[1,0,1]
    v_cvt_pk_bf16_f32 v22, v22, v23
    v_cvt_pk_bf16_f32 v23, v24, v25
    v_min_u32 v22, -2, v22
    v_min_u32 v23, -2, v23
    s_cbranch_scc1 L_slowO
    global_store_dwordx2 v53, v[22:23], s[20:21]
    s_endpgm
L_x0:
    s_cmp_eq_u32 s52, 0
    s_waitcnt vmcnt(0)
    v_mfma_f32_16x16x16_bf16 v[18:21], v[152:153], v[44:45], v[18:21]
    v_mfma_f32_16x16x16_bf16 v[14:17], v[150:151], v[44:45], v[14:17]
    s_nop 6
    ds_write_b128 v48, v[18:21] offset:2048
    v_pk_mul_f32 v[14:15], v[14:15], v[56:57] op_sel_hi:[1,0]
    v_pk_mul_f32 v[16:17], v[16:17], v[56:57] op_sel_hi:[1,0]
    s_waitcnt lgkmcnt(0)
    s_barrier
    ds_read_b128 v[22:25], v49 offset:2048
    s_waitcnt lgkmcnt(0)
    v_pk_fma_f32 v[22:23], v[22:23], v[56:57], v[14:15] op_sel:[0,1,0] op_sel_hi:[1,1,1]
    v_pk_fma_f32 v[24:25], v[24:25], v[56:57], v[16:17] op_sel:[0,1,0] op_sel_hi:[1,1,1]
    v_cvt_pk_bf16_f32 v22, v22, v23
    v_cvt_pk_bf16_f32 v23, v24, v25
    v_min_u32 v22, -2, v22
    v_min_u32 v23, -2, v23
    s_cbranch_scc1 L_slowO
    global_store_dwordx2 v53, v[22:23], s[20:21]
L_sdone:
    s_endpgm
L_slowO:
    global_store_dwordx2 v53, v[22:23], s[20:21] sc1
    s_waitcnt vmcnt(0)
    s_barrier
    s_endpgm
L_helper:
    s_load_dwordx2 s[20:21], s[0:1], 64
    v_and_b32 v51, 63, v0
    s_mov_b32 s25, 0x3e0293ee
    s_mov_b32 s26, 0xbe0293ee
    s_lshl_b32 s28, s30, 10
    v_lshl_add_u32 v48, v51, 4, s28
    s_lshl_b32 s28, s30, 5
    s_add_u32 s28, s28, 262144
    v_lshl_add_u32 v53, v51, 1, s28
    v_mov_b64 v[90:91], -1
    v_mov_b64 v[92:93], -1
    s_lshl_b32 s28, s22, 8
    v_and_b32 v52, 63, v57
    v_lshl_add_u32 v52, v52, 2, s28
    v_and_b32 v5, 1, v51
    s_bfe_u32 s29, s23, 0x20002
    s_lshl_b32 s29, s29, 6
    s_add_u32 s28, s28, s29
    s_lshr_b32 s29, s23, 4
    s_lshl_b32 s29, s29, 3
    s_add_u32 s28, s28, s29
    v_lshl_add_u32 v49, v5, 2, s28
    v_mov_b32 v7, 0
    s_waitcnt lgkmcnt(0)
    global_store_dwordx4 v48, v[90:93], s[20:21]
    s_mov_b64 exec, 0x1111
    global_store_dwordx2 v53, v[90:91], s[20:21]
    s_mov_b64 exec, -1
    global_load_dwordx4 v[10:13], v6, s[4:5]
    global_load_dwordx4 v[94:97], v52, s[10:11]
    global_load_dword v98, v49, s[12:13] offset:0
    global_load_dword v99, v49, s[12:13] offset:16
    global_load_dword v100, v49, s[12:13] offset:32
    global_load_dword v101, v49, s[12:13] offset:48
    global_load_ushort v102, v7, s[14:15]
    s_and_b32 s31, s23, 3
    s_mul_i32 s28, s22, 768
    s_lshl_b32 s29, s31, 8
    s_add_u32 s28, s28, s29
    v_add_u32 v3, s28, v49
    v_and_b32 v6, 48, v51
    v_add_u32 v3, v6, v3
    v_lshrrev_b32 v6, 1, v51
    s_lshl_b32 s28, s22, 10
    s_lshl_b32 s29, s31, 3
    s_add_u32 s28, s28, s29
    s_add_u32 s28, s28, 262144
    v_lshl_add_u32 v2, v6, 5, s28
    s_lshl_b32 s28, s22, 15
    s_lshl_b32 s29, s31, 5
    s_add_u32 s28, s28, s29
    s_bfe_u32 s29, s23, 0x20002
    s_lshl_b32 s29, s29, 7
    s_add_u32 s28, s28, s29
    s_lshr_b32 s29, s23, 4
    s_lshl_b32 s29, s29, 9
    s_add_u32 s28, s28, s29
    v_lshl_add_u32 v1, v6, 10, s28
    v_lshl_add_u32 v1, v5, 4, v1
    s_getreg_b32 s24, hwreg(HW_REG_XCC_ID, 0, 4)
    s_or_b32 s24, s24, 0x80
    s_lshl_b32 s28, s22, 5
    v_mov_b32 v5, s30
    v_mov_b32 v52, s24
    v_and_b32 v50, 7, v51
    v_lshl_add_u32 v50, v50, 2, s28
    s_mul_i32 s24, s24, 0x01010101
    s_lshl_b32 s31, s31, 2
    s_waitcnt vmcnt(0)
    s_mov_b64 exec, 1
    global_store_byte v5, v52, s[18:19]
    s_mov_b64 exec, -1
    v_mfma_f32_16x16x32_bf16 v[22:25], v[94:97], v[10:13], 0
    v_lshlrev_b32 v102, 16, v102
    v_sub_f32 v102, 1.0, v102
    s_mov_b32 s28, 0xd028965f
    v_cmp_gt_u32 vcc, 2, v51
    v_lshlrev_b32 v104, 16, v98
    v_lshlrev_b32 v105, 16, v99
    v_lshlrev_b32 v106, 16, v100
    v_lshlrev_b32 v107, 16, v101
    v_and_b32 v108, 0xffff0000, v98
    v_and_b32 v109, 0xffff0000, v99
    v_and_b32 v110, 0xffff0000, v100
    v_and_b32 v111, 0xffff0000, v101
    v_cndmask_b32 v104, 0, v104, vcc
    v_cndmask_b32 v105, 0, v105, vcc
    v_cndmask_b32 v106, 0, v106, vcc
    v_cndmask_b32 v107, 0, v107, vcc
    v_cndmask_b32 v108, 0, v108, vcc
    v_cndmask_b32 v109, 0, v109, vcc
    v_cndmask_b32 v110, 0, v110, vcc
    v_cndmask_b32 v111, 0, v111, vcc
    v_mov_b32_dpp v38, v22 quad_perm:[0,0,0,0] row_mask:0xf bank_mask:0xf
    s_nop 1
    v_add_f32_dpp v38, v23, v38 quad_perm:[1,1,1,1] row_mask:0xf bank_mask:0xf
    s_nop 1
    v_add_f32_dpp v38, v24, v38 quad_perm:[2,2,2,2] row_mask:0xf bank_mask:0xf
    s_nop 1
    v_add_f32_dpp v38, v25, v38 quad_perm:[3,3,3,3] row_mask:0xf bank_mask:0xf
    v_fma_f32 v38, v102, s28, v38
    s_nop 0
    v_readlane_b32 s31, v38, s31
    v_lshlrev_b32 v52, 3, v51
    s_mov_b32 s27, 1048576
L_armchk:
    s_sleep 8
    global_load_dword v124, v50, s[18:19] sc1
    ds_read2st64_b64 v[22:25], v52 offset0:0 offset1:1
    s_mov_b32 s52, 1
    s_waitcnt vmcnt(0) lgkmcnt(0)
    v_and_b32 v124, 0xbfbfbfbf, v124
    v_cmp_ne_u32 vcc, s24, v124
    s_cbranch_vccz L_armed
    v_max3_u32 v5, v22, v23, v24
    v_max_u32 v5, v5, v25
    v_cmp_eq_u32 vcc, -1, v5
    s_cbranch_vccnz L_armchk
    s_mov_b32 s52, 0
L_armed:
    v_mov_b32 v5, s52
    ds_write_b32 v7, v5 offset:4096
L_ldspoll:
    s_sleep 4
    ds_read2st64_b64 v[22:25], v52 offset0:0 offset1:1
    s_waitcnt lgkmcnt(0)
    v_max3_u32 v5, v22, v23, v24
    v_max_u32 v5, v5, v25
    v_cmp_eq_u32 vcc, -1, v5
    s_cbranch_vccnz L_ldspoll
    v_max_f32 v8, v22, v24
    v_mul_f32 v7, s26, v8
    v_fma_f32 v42, v22, s25, v7
    v_fma_f32 v43, v24, s25, v7
    v_exp_f32 v42, v42
    v_exp_f32 v43, v43
    s_cmp_eq_u32 s52, 0
    v_mul_f32 v9, v42, v23
    v_fma_f32 v9, v43, v25, v9
    v_min_u32 v42, -2, v42
    ds_write_b64 v52, v[42:43] offset:1024
    v_min_u32 v9, -2, v9
    s_mov_b64 exec, 0x1111
    s_cbranch_scc1 L_slowM
    global_store_dwordx2 v53, v[8:9], s[20:21]
L_mgo:
    s_mov_b64 exec, -1
L_pollM:
    s_sleep 4
    global_load_dwordx2 v[120:121], v2, s[20:21] sc1
    s_sub_u32 s27, s27, 1
    s_cbranch_scc1 L_mto
    s_waitcnt vmcnt(0)
    v_max_u32 v6, v120, v121
    v_cmp_eq_u32 vcc, -1, v6
    s_cbranch_vccnz L_pollM
L_mto:
    v_max_f32 v6, s31, v120
    v_mov_b32 v5, v6
    s_nop 1
    v_permlane32_swap_b32 v6, v5
    v_max_f32 v6, v6, v5
    v_mov_b32 v5, v6
    s_nop 1
    v_permlane16_swap_b32 v6, v5
    v_max_f32 v6, v6, v5
    s_nop 1
    v_max_f32_dpp v6, v6, v6 row_ror:8 row_mask:0xf bank_mask:0xf
    s_nop 1
    v_max_f32_dpp v6, v6, v6 row_ror:4 row_mask:0xf bank_mask:0xf
    s_nop 1
    v_max_f32_dpp v6, v6, v6 quad_perm:[2,3,0,1] row_mask:0xf bank_mask:0xf
    v_sub_f32 v122, v120, v6
    v_sub_f32 v56, s31, v6
    v_mul_f32 v122, s25, v122
    v_mul_f32 v56, s25, v56
    v_exp_f32 v122, v122
    v_exp_f32 v56, v56
    v_mul_f32 v6, v122, v121
    v_mov_b32 v5, v6
    s_nop 1
    v_permlane32_swap_b32 v6, v5
    v_add_f32 v6, v6, v5
    v_mov_b32 v5, v6
    s_nop 1
    v_permlane16_swap_b32 v6, v5
    v_add_f32 v6, v6, v5
    s_nop 1
    v_add_f32_dpp v6, v6, v6 row_ror:8 row_mask:0xf bank_mask:0xf
    s_nop 1
    v_add_f32_dpp v6, v6, v6 row_ror:4 row_mask:0xf bank_mask:0xf
    s_nop 1
    v_add_f32_dpp v6, v6, v6 quad_perm:[2,3,0,1] row_mask:0xf bank_mask:0xf
    v_add_f32 v6, v6, v56
    v_rcp_f32 v6, v6
    s_nop 0
    v_mul_f32 v122, v122, v6
    v_mul_f32 v56, v56, v6
    v_pk_mul_f32 v[104:105], v[104:105], v[56:57] op_sel_hi:[1,0]
    v_pk_mul_f32 v[106:107], v[106:107], v[56:57] op_sel_hi:[1,0]
    v_pk_mul_f32 v[108:109], v[108:109], v[56:57] op_sel_hi:[1,0]
    v_pk_mul_f32 v[110:111], v[110:111], v[56:57] op_sel_hi:[1,0]
    s_mov_b32 s27, 1048576
    s_mov_b32 s48, 0x00030003
    s_mov_b32 s49, 0x00030003
    s_cmp_eq_u32 s52, 0
    s_cbranch_scc1 L_pollO
    s_waitcnt lgkmcnt(0)
    s_barrier
L_pollO:
    global_load_dwordx4 v[112:115], v1, s[20:21] sc1
    s_sleep 1
    s_sub_u32 s27, s27, 1
    s_cbranch_scc1 L_fin
    s_waitcnt vmcnt(0)
    v_max3_u32 v5, v112, v113, v114
    v_max_u32 v5, v5, v115
    v_cmp_eq_u32 vcc, -1, v5
    s_bcnt1_i32_b64 s29, vcc
    s_cbranch_scc0 L_done
    s_mov_b64 exec, vcc
    s_cmp_gt_u32 s29, 8
    s_cbranch_scc1 L_pollO
L_pollO2:
    global_load_dwordx4 v[112:115], v1, s[20:21] sc1
    s_sub_u32 s27, s27, 1
    s_cbranch_scc1 L_fin
    s_waitcnt vmcnt(4)
    v_max3_u32 v5, v112, v113, v114
    v_max_u32 v5, v5, v115
    v_cmp_eq_u32 vcc, -1, v5
    s_and_b64 exec, exec, vcc
    s_cbranch_scc1 L_pollO2
L_done:
    s_mov_b64 exec, -1
    v_lshlrev_b32 v22, 16, v112
    v_and_b32 v23, 0xffff0000, v112
    v_lshlrev_b32 v24, 16, v113
    v_and_b32 v25, 0xffff0000, v113
    v_lshlrev_b32 v26, 16, v114
    v_and_b32 v27, 0xffff0000, v114
    v_lshlrev_b32 v28, 16, v115
    v_and_b32 v29, 0xffff0000, v115
    v_pk_fma_f32 v[104:105], v[22:23], v[122:123], v[104:105] op_sel_hi:[1,0,1]
    v_pk_fma_f32 v[106:107], v[24:25], v[122:123], v[106:107] op_sel_hi:[1,0,1]
    v_pk_fma_f32 v[108:109], v[26:27], v[122:123], v[108:109] op_sel_hi:[1,0,1]
    v_pk_fma_f32 v[110:111], v[28:29], v[122:123], v[110:111] op_sel_hi:[1,0,1]
    v_permlane32_swap_b32 v104, v106
    v_permlane32_swap_b32 v105, v107
    v_permlane32_swap_b32 v108, v110
    v_permlane32_swap_b32 v109, v111
    v_pk_add_f32 v[104:105], v[104:105], v[106:107]
    v_pk_add_f32 v[108:109], v[108:109], v[110:111]
    s_nop 0
    v_permlane16_swap_b32 v104, v105
    v_permlane16_swap_b32 v108, v109
    v_add_f32 v104, v104, v105
    v_add_f32 v108, v108, v109
    s_nop 0
    v_add_f32_dpp v104, v104, v104 row_ror:8 row_mask:0xf bank_mask:0xf
    v_add_f32_dpp v108, v108, v108 row_ror:8 row_mask:0xf bank_mask:0xf
    s_nop 0
    v_add_f32_dpp v104, v104, v104 row_ror:4 row_mask:0xf bank_mask:0xf
    v_add_f32_dpp v108, v108, v108 row_ror:4 row_mask:0xf bank_mask:0xf
    s_nop 0
    v_add_f32_dpp v104, v104, v104 quad_perm:[2,3,0,1] row_mask:0xf bank_mask:0xf
    v_add_f32_dpp v108, v108, v108 quad_perm:[2,3,0,1] row_mask:0xf bank_mask:0xf
    s_mov_b64 exec, s[48:49]
    v_cvt_pk_bf16_f32 v104, v104, v108
    global_store_dword v3, v104, s[16:17]
L_fin:
L_end:
    s_endpgm
L_slowM:
    global_store_dwordx2 v53, v[8:9], s[20:21] sc1
    s_mov_b64 exec, -1
    s_waitcnt lgkmcnt(0)
    s_barrier
    s_and_b32 s28, s30, 0xfc
    s_and_b32 s29, s23, 3
    s_lshl_b32 s29, s29, 3
    s_lshl_b32 s29, 0x40, s29
    v_mov_b32 v5, s28
    v_mov_b32 v52, s29
    v_mov_b32 v7, 0
    s_waitcnt vmcnt(0)
    s_barrier
    s_mov_b64 exec, 1
    global_atomic_or v5, v52, s[18:19]
L_slowwait:
    s_mov_b64 exec, 0xff
    global_atomic_or v6, v50, v7, s[18:19] sc0
    global_load_dword v124, v50, s[18:19] sc1
    s_waitcnt vmcnt(0)
    v_and_b32 v6, 0x40404040, v6
    v_cmp_ne_u32 vcc, 0x40404040, v6
    s_cbranch_vccz L_mgo
    v_and_b32 v124, 0xbfbfbfbf, v124
    v_cmp_ne_u32 vcc, s24, v124
    s_cbranch_vccz L_mgo
    s_sleep 32
    s_sub_u32 s27, s27, 1
    s_cbranch_scc0 L_slowwait
    s_branch L_fin
L_codeend:
.section .rodata,"a"
.p2align 6
.amdhsa_kernel standalone__tree_speculative_verify_tree_attention_over_candidate_token_tree__decode_kernel
  .amdhsa_next_free_vgpr 154
  .amdhsa_next_free_sgpr 64
  .amdhsa_accum_offset 156
  .amdhsa_group_segment_fixed_size 0
  .amdhsa_kernarg_size 72
  .amdhsa_user_sgpr_count 2
  .amdhsa_user_sgpr_kernarg_segment_ptr 1
  .amdhsa_system_sgpr_workgroup_id_x 1
.end_amdhsa_kernel
```
